```python
import torch

def _softmax(x, axis=-1):
    return torch.softmax(x, dim=axis)
def _gelu(x):
    return torch.nn.functional.gelu(x, approximate="tanh")
def _silu(x):
    return torch.nn.functional.silu(x)
def _sigmoid(x):
    return torch.sigmoid(x)
def _layernorm(x, axis=-1, eps=1e-5):
    m = x.mean(dim=axis, keepdim=True)
    v = x.var(dim=axis, keepdim=True, unbiased=False)
    return (x - m) / torch.sqrt(v + eps)
def _scatter_add(tgt, idx, src, axis=0):
    return tgt.clone().index_add_(axis, idx, src)
def _segment_sum(src, seg, n):
    out = torch.zeros((n,) + src.shape[1:], dtype=src.dtype)
    return out.index_add_(0, seg, src)
def _pad(x, pw):
    flat = tuple(v for pair in reversed(pw) for v in pair)
    return torch.nn.functional.pad(x, flat)

kernel_name = 'standalone__mha_block_cached__near_ridge'

def setup_inputs():

    _w = (lambda a: (lambda t: t.to(torch.bfloat16) if t.is_floating_point() else t)(torch.as_tensor(a)))
    B, Sq, D = 8, 64, 1024
    H, Sk, Dh = 32, 64, 128
    return {
        "x": _w((lambda *s: torch.randn(*s, dtype=torch.bfloat16) * 0.8)(B, Sq, D)),
        "k_cache": _w((lambda *s: torch.randn(*s, dtype=torch.bfloat16) * 0.8)(B, H, Sk, Dh)),
        "v_cache": _w((lambda *s: torch.randn(*s, dtype=torch.bfloat16) * 0.05)(B, H, Sk, Dh)),
        "wq": _w((lambda *s: torch.randn(*s, dtype=torch.bfloat16) * 0.8)(D, H * Dh) * (D ** -0.5)),
        "wo": _w((lambda *s: torch.randn(*s, dtype=torch.bfloat16) * 0.05)(H * Dh, D) * ((H * Dh) ** -0.5)),
    }

def reference(x, k_cache, v_cache, wq, wo):
    B, Sq, D = x.shape
    H, Dh = 32, 128
    q = (lambda x, *d: x.permute(*d))((x @ wq).reshape(B, Sq, H, Dh), 0, 2, 1, 3)
    scores = torch.einsum("bhqd,bhkd->bhqk", q, k_cache) * (Dh ** -0.5)
    p = _softmax(scores, axis=-1)
    o = torch.einsum("bhqk,bhkd->bhqd", p, v_cache)
    return (lambda x, *d: x.permute(*d))(o, 0, 2, 1, 3).reshape(B, Sq, H * Dh) @ wo
```

```asm
; @launch kernel=mha_k1_kernel grid=(256,1,1) block=(512,1,1) lds=131072
; @launch kernel=mha_k2_kernel grid=(256,1,1) block=(512,1,1) lds=131072
.amdgcn_target "amdgcn-amd-amdhsa--gfx950"
.text
.globl mha_k1_kernel
.p2align 8
.type mha_k1_kernel,@function
mha_k1_kernel:
    s_cmp_ge_u32 s2, 256
    s_cbranch_scc1 k1_END
    s_load_dwordx8 s[4:11], s[0:1], 0
    s_load_dwordx2 s[12:13], s[0:1], 56
    s_load_dwordx2 s[14:15], s[0:1], 32
    s_load_dwordx2 s[58:59], s[0:1], 40
    v_and_b32 v1, 63, v0
    v_lshrrev_b32 v14, 6, v0
    s_nop 0
    v_readfirstlane_b32 s36, v14
    s_and_b32 s48, s2, 7
    s_lshl_b32 s48, s48, 2
    s_bfe_u32 s49, s2, 0x20003
    s_add_u32 s38, s48, s49
    s_lshr_b32 s37, s2, 5
    s_and_b32 s56, s36, 3
    s_lshr_b32 s55, s36, 2
    s_and_b32 s48, s38, 3
    s_lshl_b32 s48, s48, 1
    s_add_u32 s48, s48, s37
    s_lshl_b32 s48, s48, 1
    s_and_b32 s39, s48, 15
    s_mov_b32 s40, 0
    s_lshl_b32 s43, s38, 8
    s_lshl_b32 s44, s37, 17
    s_lshl_b32 s45, s36, 11
    s_lshl_b32 s46, s36, 10
    s_add_u32 s46, s46, 16384
    s_lshl_b32 s48, s37, 5
    s_add_u32 s48, s48, s38
    s_lshl_b32 s52, s48, 14
    v_lshrrev_b32 v14, 4, v1
    v_and_b32 v15, 15, v1
    v_lshlrev_b32 v252, 2, v14
    v_xor_b32 v15, v15, v252
    v_lshlrev_b32 v2, 13, v14
    v_lshl_add_u32 v2, v15, 4, v2
    s_lshl_b32 s48, s36, 16
    v_add_u32 v2, s48, v2
    v_lshrrev_b32 v15, 3, v1
    v_and_b32 v252, 7, v1
    v_xor_b32 v252, v252, v14
    s_and_b32 s48, s36, 1
    s_lshl_b32 s48, s48, 2
    v_xor_b32 v252, s48, v252
    v_lshlrev_b32 v3, 11, v15
    v_lshl_add_u32 v3, v252, 4, v3
    s_lshl_b32 s48, s36, 14
    v_add_u32 v3, s48, v3
    v_lshrrev_b32 v14, 5, v1
    v_lshlrev_b32 v4, 11, v14
    v_bfe_u32 v14, v1, 2, 2
    v_lshl_add_u32 v4, v14, 8, v4
    v_xor_b32 v14, s56, v14
    v_lshl_add_u32 v4, v14, 6, v4
    v_bfe_u32 v14, v1, 4, 1
    v_lshl_add_u32 v4, v14, 5, v4
    v_and_b32 v14, 3, v1
    v_lshl_add_u32 v4, v14, 3, v4
    s_lshl_b32 s48, s55, 13
    v_add_u32 v4, s48, v4
    v_add_u32 v7, 49152, v4
    v_and_b32 v14, 31, v1
    v_lshlrev_b32 v14, 7, v14
    v_lshrrev_b32 v15, 5, v1
    v_bfe_u32 v252, v1, 1, 3
    v_xor_b32 v15, v15, v252
    s_lshl_b32 s48, s55, 2
    v_xor_b32 v15, s48, v15
    v_lshl_add_u32 v14, v15, 4, v14
    s_lshl_b32 s48, s55, 12
    v_add_u32 v5, s48, v14
    v_xor_b32 v10, 32, v5
    v_xor_b32 v8, 4096, v5
    v_xor_b32 v12, 4096, v10
    v_add_u32 v6, 49152, v5
    v_add_u32 v9, 49152, v8
    v_add_u32 v11, 49152, v10
    v_add_u32 v13, 49152, v12
    v_mov_b32 v64, 0
    v_mov_b32 v65, 0
    v_mov_b32 v66, 0
    v_mov_b32 v67, 0
    v_mov_b32 v68, 0
    v_mov_b32 v69, 0
    v_mov_b32 v70, 0
    v_mov_b32 v71, 0
    v_mov_b32 v72, 0
    v_mov_b32 v73, 0
    v_mov_b32 v74, 0
    v_mov_b32 v75, 0
    v_mov_b32 v76, 0
    v_mov_b32 v77, 0
    v_mov_b32 v78, 0
    v_mov_b32 v79, 0
    v_mov_b32 v80, 0
    v_mov_b32 v81, 0
    v_mov_b32 v82, 0
    v_mov_b32 v83, 0
    v_mov_b32 v84, 0
    v_mov_b32 v85, 0
    v_mov_b32 v86, 0
    v_mov_b32 v87, 0
    v_mov_b32 v88, 0
    v_mov_b32 v89, 0
    v_mov_b32 v90, 0
    v_mov_b32 v91, 0
    v_mov_b32 v92, 0
    v_mov_b32 v93, 0
    v_mov_b32 v94, 0
    v_mov_b32 v95, 0
    v_mov_b32 v24, 0
    v_mov_b32 v25, 0
    v_mov_b32 v26, 0
    v_mov_b32 v27, 0
    v_mov_b32 v28, 0
    v_mov_b32 v29, 0
    v_mov_b32 v30, 0
    v_mov_b32 v31, 0
    v_mov_b32 v48, 0
    v_mov_b32 v49, 0
    v_mov_b32 v50, 0
    v_mov_b32 v51, 0
    v_mov_b32 v52, 0
    v_mov_b32 v53, 0
    v_mov_b32 v54, 0
    v_mov_b32 v55, 0
    v_mov_b32 v56, 0
    v_mov_b32 v57, 0
    v_mov_b32 v58, 0
    v_mov_b32 v59, 0
    v_mov_b32 v60, 0
    v_mov_b32 v61, 0
    v_mov_b32 v62, 0
    v_mov_b32 v63, 0
    s_waitcnt lgkmcnt(0)
    s_mov_b32 s16, s4
    s_and_b32 s17, s5, 0xffff
    s_mov_b32 s18, 0x100000
    s_mov_b32 s19, 0x00020000
    s_mov_b32 s20, s10
    s_and_b32 s21, s11, 0xffff
    s_mov_b32 s22, 0x800000
    s_mov_b32 s23, 0x00020000
    s_add_u32 s48, s40, s39
    s_and_b32 s48, s48, 15
    s_lshl_b32 s49, s48, 19
    s_add_u32 s41, s43, s49
    s_add_u32 m0, s45, 0
    s_lshl_b32 s51, s48, 7
    buffer_load_dwordx4 v2, s[20:23], s41 offen  lds
    s_add_u32 s57, s41, 32768
    s_add_u32 m0, s45, 1024
    s_add_u32 s42, s44, s51
    buffer_load_dwordx4 v2, s[20:23], s57 offen  lds
    s_add_u32 m0, s46, 0
    s_add_u32 s40, s40, 1
    buffer_load_dwordx4 v3, s[16:19], s42 offen  lds
    s_add_u32 s48, s40, s39
    s_and_b32 s48, s48, 15
    s_lshl_b32 s49, s48, 19
    s_add_u32 s41, s43, s49
    s_add_u32 m0, s45, 24576
    s_lshl_b32 s51, s48, 7
    buffer_load_dwordx4 v2, s[20:23], s41 offen  lds
    s_add_u32 s57, s41, 32768
    s_add_u32 m0, s45, 25600
    s_add_u32 s42, s44, s51
    buffer_load_dwordx4 v2, s[20:23], s57 offen  lds
    s_add_u32 m0, s46, 24576
    s_add_u32 s40, s40, 1
    buffer_load_dwordx4 v3, s[16:19], s42 offen  lds
    s_add_u32 s48, s40, s39
    s_and_b32 s48, s48, 15
    s_lshl_b32 s49, s48, 19
    s_add_u32 s41, s43, s49
    s_add_u32 m0, s45, 49152
    s_lshl_b32 s51, s48, 7
    buffer_load_dwordx4 v2, s[20:23], s41 offen  lds
    s_add_u32 s57, s41, 32768
    s_add_u32 m0, s45, 50176
    s_add_u32 s42, s44, s51
    buffer_load_dwordx4 v2, s[20:23], s57 offen  lds
    s_add_u32 m0, s46, 49152
    s_add_u32 s40, s40, 1
    buffer_load_dwordx4 v3, s[16:19], s42 offen  lds
    s_mov_b32 s24, s6
    s_and_b32 s25, s7, 0xffff
    s_mov_b32 s26, 0x400000
    s_mov_b32 s27, 0x00020000
    s_mov_b32 s28, s8
    s_and_b32 s29, s9, 0xffff
    s_mov_b32 s30, 0x400000
    s_mov_b32 s31, 0x00020000
    s_mov_b32 s32, s12
    s_and_b32 s33, s13, 0xffff
    s_mov_b32 s34, 0x400000
    s_mov_b32 s35, 0x00020000
    v_lshrrev_b32 v14, 4, v1
    v_and_b32 v15, 15, v1
    v_lshlrev_b32 v252, 8, v14
    s_lshl_b32 s48, s36, 11
    v_add_u32 v252, s48, v252
    v_xor_b32 v253, v15, v14
    s_and_b32 s48, s36, 1
    s_lshl_b32 s48, s48, 3
    v_xor_b32 v253, s48, v253
    v_lshl_add_u32 v246, v253, 4, v252
    v_xor_b32 v253, 4, v253
    v_lshl_add_u32 v247, v253, 4, v252
    v_add_u32 v247, 1024, v247
    v_lshlrev_b32 v253, 1, v14
    v_xor_b32 v253, v15, v253
    v_lshl_add_u32 v248, v253, 4, v252
    v_xor_b32 v253, 8, v253
    v_lshl_add_u32 v249, v253, 4, v252
    v_add_u32 v249, 1024, v249
    s_mov_b32 s47, 4
k1_LOOP:
    s_waitcnt vmcnt(6)
    s_barrier
    ds_read_b64_tr_b16 v[16:17], v4 offset:0
    ds_read_b64_tr_b16 v[18:19], v4 offset:1024
    ds_read_b128 v[32:35], v5 offset:16384
    ds_read_b128 v[36:39], v8 offset:16384
    ds_read_b64_tr_b16 v[20:21], v4 offset:4096
    ds_read_b64_tr_b16 v[22:23], v4 offset:5120
    ds_read_b128 v[40:43], v10 offset:16384
    ds_read_b128 v[44:47], v12 offset:16384
    v_mfma_f32_32x32x16_bf16 v[64:79], v[24:27], v[48:51], v[64:79]
    s_add_u32 s48, s40, s39
    s_and_b32 s48, s48, 15
    s_lshl_b32 s49, s48, 19
    s_add_u32 s41, s43, s49
    s_add_u32 m0, s45, 73728
    s_lshl_b32 s51, s48, 7
    buffer_load_dwordx4 v2, s[20:23], s41 offen  lds
    v_mfma_f32_32x32x16_bf16 v[80:95], v[24:27], v[52:55], v[80:95]
    s_add_u32 s57, s41, 32768
    s_add_u32 m0, s45, 74752
    s_add_u32 s42, s44, s51
    buffer_load_dwordx4 v2, s[20:23], s57 offen  lds
    v_mfma_f32_32x32x16_bf16 v[64:79], v[28:31], v[56:59], v[64:79]
    s_add_u32 m0, s46, 73728
    s_add_u32 s40, s40, 1
    buffer_load_dwordx4 v3, s[16:19], s42 offen  lds
    v_mfma_f32_32x32x16_bf16 v[80:95], v[28:31], v[60:63], v[80:95]
    s_cmp_lg_u32 s47, 3
    s_cbranch_scc1 k1_NKV0c
    s_add_u32 m0, s45, 98304
    s_nop 0
    buffer_load_dwordx4 v246, s[24:27], s52 offen nt lds
k1_NKV0c:
    s_waitcnt lgkmcnt(0)
    s_waitcnt vmcnt(6)
    s_barrier
    ds_read_b64_tr_b16 v[24:25], v4 offset:24576
    ds_read_b64_tr_b16 v[26:27], v4 offset:25600
    ds_read_b128 v[48:51], v5 offset:40960
    ds_read_b128 v[52:55], v8 offset:40960
    ds_read_b64_tr_b16 v[28:29], v4 offset:28672
    ds_read_b64_tr_b16 v[30:31], v4 offset:29696
    ds_read_b128 v[56:59], v10 offset:40960
    ds_read_b128 v[60:63], v12 offset:40960
    s_add_u32 s50, s45, 0x28000
    s_add_u32 s51, s46, 0x28000
    s_cmp_eq_u32 s47, 1
    s_cselect_b32 s22, 0, s22
    s_cselect_b32 s18, 0, s18
    s_cselect_b32 s45, s50, s45
    s_cselect_b32 s46, s51, s46
    v_mfma_f32_32x32x16_bf16 v[64:79], v[16:19], v[32:35], v[64:79]
    s_add_u32 s48, s40, s39
    s_and_b32 s48, s48, 15
    s_lshl_b32 s49, s48, 19
    s_add_u32 s41, s43, s49
    s_add_u32 m0, s45, 0
    s_lshl_b32 s51, s48, 7
    buffer_load_dwordx4 v2, s[20:23], s41 offen  lds
    v_mfma_f32_32x32x16_bf16 v[80:95], v[16:19], v[36:39], v[80:95]
    s_add_u32 s57, s41, 32768
    s_add_u32 m0, s45, 1024
    s_add_u32 s42, s44, s51
    buffer_load_dwordx4 v2, s[20:23], s57 offen  lds
    v_mfma_f32_32x32x16_bf16 v[64:79], v[20:23], v[40:43], v[64:79]
    s_add_u32 m0, s46, 0
    s_add_u32 s40, s40, 1
    buffer_load_dwordx4 v3, s[16:19], s42 offen  lds
    v_mfma_f32_32x32x16_bf16 v[80:95], v[20:23], v[44:47], v[80:95]
    s_cmp_lg_u32 s47, 3
    s_cbranch_scc1 k1_NKV1c
    s_add_u32 m0, s45, 99328
    s_nop 0
    buffer_load_dwordx4 v247, s[24:27], s52 offen nt lds
k1_NKV1c:
    s_waitcnt lgkmcnt(0)
    s_waitcnt vmcnt(6)
    s_barrier
    ds_read_b64_tr_b16 v[16:17], v7 offset:0
    ds_read_b64_tr_b16 v[18:19], v7 offset:1024
    ds_read_b128 v[32:35], v6 offset:16384
    ds_read_b128 v[36:39], v9 offset:16384
    ds_read_b64_tr_b16 v[20:21], v7 offset:4096
    ds_read_b64_tr_b16 v[22:23], v7 offset:5120
    ds_read_b128 v[40:43], v11 offset:16384
    ds_read_b128 v[44:47], v13 offset:16384
    v_mfma_f32_32x32x16_bf16 v[64:79], v[24:27], v[48:51], v[64:79]
    s_add_u32 s48, s40, s39
    s_and_b32 s48, s48, 15
    s_lshl_b32 s49, s48, 19
    s_add_u32 s41, s43, s49
    s_add_u32 m0, s45, 24576
    s_lshl_b32 s51, s48, 7
    buffer_load_dwordx4 v2, s[20:23], s41 offen  lds
    v_mfma_f32_32x32x16_bf16 v[80:95], v[24:27], v[52:55], v[80:95]
    s_add_u32 s57, s41, 32768
    s_add_u32 m0, s45, 25600
    s_add_u32 s42, s44, s51
    buffer_load_dwordx4 v2, s[20:23], s57 offen  lds
    v_mfma_f32_32x32x16_bf16 v[64:79], v[28:31], v[56:59], v[64:79]
    s_add_u32 m0, s46, 24576
    s_add_u32 s40, s40, 1
    buffer_load_dwordx4 v3, s[16:19], s42 offen  lds
    v_mfma_f32_32x32x16_bf16 v[80:95], v[28:31], v[60:63], v[80:95]
    s_cmp_lg_u32 s47, 3
    s_cbranch_scc1 k1_NKV2c
    s_add_u32 m0, s45, 114688
    s_nop 0
    buffer_load_dwordx4 v248, s[28:31], s52 offen nt lds
k1_NKV2c:
    s_waitcnt lgkmcnt(0)
    s_waitcnt vmcnt(6)
    s_barrier
    ds_read_b64_tr_b16 v[24:25], v7 offset:24576
    ds_read_b64_tr_b16 v[26:27], v7 offset:25600
    ds_read_b128 v[48:51], v6 offset:40960
    ds_read_b128 v[52:55], v9 offset:40960
    ds_read_b64_tr_b16 v[28:29], v7 offset:28672
    ds_read_b64_tr_b16 v[30:31], v7 offset:29696
    ds_read_b128 v[56:59], v11 offset:40960
    ds_read_b128 v[60:63], v13 offset:40960
    v_mfma_f32_32x32x16_bf16 v[64:79], v[16:19], v[32:35], v[64:79]
    s_add_u32 s48, s40, s39
    s_and_b32 s48, s48, 15
    s_lshl_b32 s49, s48, 19
    s_add_u32 s41, s43, s49
    s_add_u32 m0, s45, 49152
    s_lshl_b32 s51, s48, 7
    buffer_load_dwordx4 v2, s[20:23], s41 offen  lds
    v_mfma_f32_32x32x16_bf16 v[80:95], v[16:19], v[36:39], v[80:95]
    s_add_u32 s57, s41, 32768
    s_add_u32 m0, s45, 50176
    s_add_u32 s42, s44, s51
    buffer_load_dwordx4 v2, s[20:23], s57 offen  lds
    v_mfma_f32_32x32x16_bf16 v[64:79], v[20:23], v[40:43], v[64:79]
    s_add_u32 m0, s46, 49152
    s_add_u32 s40, s40, 1
    buffer_load_dwordx4 v3, s[16:19], s42 offen  lds
    v_mfma_f32_32x32x16_bf16 v[80:95], v[20:23], v[44:47], v[80:95]
    s_cmp_lg_u32 s47, 3
    s_cbranch_scc1 k1_NKV3c
    s_add_u32 m0, s45, 115712
    s_nop 0
    buffer_load_dwordx4 v249, s[28:31], s52 offen nt lds
k1_NKV3c:
    s_waitcnt lgkmcnt(0)
    s_sub_u32 s47, s47, 1
    s_cmp_lg_u32 s47, 0
    s_cbranch_scc1 k1_LOOP
    v_mfma_f32_32x32x16_bf16 v[64:79], v[24:27], v[48:51], v[64:79]
    v_mfma_f32_32x32x16_bf16 v[80:95], v[24:27], v[52:55], v[80:95]
    v_mfma_f32_32x32x16_bf16 v[64:79], v[28:31], v[56:59], v[64:79]
    v_mfma_f32_32x32x16_bf16 v[80:95], v[28:31], v[60:63], v[80:95]
    s_nop 15
    s_waitcnt vmcnt(0)
    s_mov_b32 s16, s14
    s_and_b32 s17, s15, 0xffff
    s_mov_b32 s18, 0x800000
    s_mov_b32 s19, 0x00020000
    v_lshrrev_b32 v252, 2, v1
    v_lshlrev_b32 v252, 11, v252
    v_and_b32 v253, 3, v1
    v_lshl_add_u32 v252, v253, 7, v252
    s_bfe_u32 s48, s2, 0x20001
    s_lshl_b32 s48, s48, 9
    s_lshr_b32 s49, s2, 3
    s_lshl_b32 s49, s49, 18
    s_add_u32 s48, s48, s49
    s_lshl_b32 s49, s36, 15
    s_add_u32 s48, s48, s49
    buffer_load_dword v16, v252, s[16:19], s48 offen
    v_lshlrev_b32 v14, 4, v1
    s_lshl_b32 s48, s36, 12
    v_add_u32 v15, s48, v14
    ds_write_b128 v15, v[80:83] offset:0
    ds_write_b128 v15, v[84:87] offset:1024
    ds_write_b128 v15, v[88:91] offset:2048
    ds_write_b128 v15, v[92:95] offset:3072
    s_xor_b32 s48, s36, 4
    s_lshl_b32 s48, s48, 12
    v_add_u32 v15, s48, v14
    s_waitcnt lgkmcnt(0)
    s_barrier
    ds_read_b128 v[80:83], v15 offset:0
    ds_read_b128 v[84:87], v15 offset:1024
    ds_read_b128 v[88:91], v15 offset:2048
    ds_read_b128 v[92:95], v15 offset:3072
    v_and_b32 v252, 31, v1
    v_lshlrev_b32 v252, 8, v252
    s_lshl_b32 s48, s55, 13
    v_add_u32 v252, s48, v252
    v_and_b32 v253, 15, v1
    s_lshl_b32 s48, s56, 2
    v_xor_b32 v253, s48, v253
    v_lshl_add_u32 v252, v253, 4, v252
    v_lshrrev_b32 v253, 5, v1
    v_lshl_add_u32 v252, v253, 3, v252
    v_xor_b32 v253, 16, v252
    v_xor_b32 v254, 32, v252
    v_xor_b32 v255, 48, v252
    s_waitcnt lgkmcnt(0)
    v_add_f32 v64, v64, v80
    v_add_f32 v65, v65, v81
    v_add_f32 v66, v66, v82
    v_add_f32 v67, v67, v83
    v_add_f32 v68, v68, v84
    v_add_f32 v69, v69, v85
    v_add_f32 v70, v70, v86
    v_add_f32 v71, v71, v87
    v_add_f32 v72, v72, v88
    v_add_f32 v73, v73, v89
    v_add_f32 v74, v74, v90
    v_add_f32 v75, v75, v91
    v_add_f32 v76, v76, v92
    v_add_f32 v77, v77, v93
    v_add_f32 v78, v78, v94
    v_add_f32 v79, v79, v95
    v_cvt_pk_bf16_f32 v80, v64, v65
    v_cvt_pk_bf16_f32 v81, v66, v67
    v_cvt_pk_bf16_f32 v82, v68, v69
    v_cvt_pk_bf16_f32 v83, v70, v71
    v_cvt_pk_bf16_f32 v84, v72, v73
    v_cvt_pk_bf16_f32 v85, v74, v75
    v_cvt_pk_bf16_f32 v86, v76, v77
    v_cvt_pk_bf16_f32 v87, v78, v79
    ds_write_b64 v252, v[80:81] offset:32768
    ds_write_b64 v253, v[82:83] offset:32768
    ds_write_b64 v254, v[84:85] offset:32768
    ds_write_b64 v255, v[86:87] offset:32768
    s_waitcnt lgkmcnt(0)
    s_barrier
    v_and_b32 v14, 15, v1
    v_lshrrev_b32 v15, 4, v1
    v_xor_b32 v15, v15, v14
    v_lshlrev_b32 v14, 8, v14
    v_lshl_add_u32 v14, v15, 4, v14
    v_add_u32 v2, 98304, v14
    v_xor_b32 v3, 64, v2
    v_xor_b32 v4, 128, v2
    v_xor_b32 v5, 192, v2
    s_lshl_b32 s48, s56, 12
    s_add_u32 s48, s48, 32768
    v_add_u32 v6, s48, v14
    v_xor_b32 v7, 64, v6
    v_xor_b32 v8, 128, v6
    v_xor_b32 v9, 192, v6
    ds_read_b128 v[96:99], v6
    ds_read_b128 v[100:103], v7
    ds_read_b128 v[104:107], v8
    ds_read_b128 v[108:111], v9
    ds_read_b128 v[112:115], v2 offset:0
    ds_read_b128 v[116:119], v3 offset:0
    ds_read_b128 v[120:123], v4 offset:0
    ds_read_b128 v[124:127], v5 offset:0
    ds_read_b128 v[128:131], v2 offset:4096
    ds_read_b128 v[132:135], v3 offset:4096
    ds_read_b128 v[136:139], v4 offset:4096
    ds_read_b128 v[140:143], v5 offset:4096
    v_lshrrev_b32 v14, 2, v1
    v_lshlrev_b32 v15, 8, v14
    v_bfe_u32 v252, v1, 4, 1
    v_lshlrev_b32 v252, 3, v252
    v_bfe_u32 v253, v1, 2, 2
    v_lshl_add_u32 v252, v253, 1, v252
    v_lshl_add_u32 v15, v252, 4, v15
    v_and_b32 v253, 3, v1
    v_lshl_add_u32 v15, v253, 3, v15
    s_lshl_b32 s48, s55, 7
    v_xor_b32 v15, s48, v15
    v_add_u32 v10, 114688, v15
    v_xor_b32 v11, 32, v10
    v_xor_b32 v12, 64, v10
    v_xor_b32 v13, 96, v10
    s_waitcnt lgkmcnt(4)
    v_mfma_f32_16x16x32_bf16 v[176:179], v[112:115], v[96:99], 0
    v_mfma_f32_16x16x32_bf16 v[176:179], v[116:119], v[100:103], v[176:179]
    v_mfma_f32_16x16x32_bf16 v[176:179], v[120:123], v[104:107], v[176:179]
    v_mfma_f32_16x16x32_bf16 v[176:179], v[124:127], v[108:111], v[176:179]
    ds_read_b128 v[144:147], v2 offset:8192
    ds_read_b128 v[148:151], v3 offset:8192
    ds_read_b128 v[152:155], v4 offset:8192
    ds_read_b128 v[156:159], v5 offset:8192
    s_waitcnt lgkmcnt(4)
    v_mfma_f32_16x16x32_bf16 v[180:183], v[128:131], v[96:99], 0
    v_mfma_f32_16x16x32_bf16 v[180:183], v[132:135], v[100:103], v[180:183]
    v_mfma_f32_16x16x32_bf16 v[180:183], v[136:139], v[104:107], v[180:183]
    v_mfma_f32_16x16x32_bf16 v[180:183], v[140:143], v[108:111], v[180:183]
    ds_read_b128 v[160:163], v2 offset:12288
    ds_read_b128 v[164:167], v3 offset:12288
    ds_read_b128 v[168:171], v4 offset:12288
    ds_read_b128 v[172:175], v5 offset:12288
    s_waitcnt lgkmcnt(4)
    v_mfma_f32_16x16x32_bf16 v[184:187], v[144:147], v[96:99], 0
    v_mfma_f32_16x16x32_bf16 v[184:187], v[148:151], v[100:103], v[184:187]
    v_mfma_f32_16x16x32_bf16 v[184:187], v[152:155], v[104:107], v[184:187]
    v_mfma_f32_16x16x32_bf16 v[184:187], v[156:159], v[108:111], v[184:187]
    ds_read_b64_tr_b16 v[192:193], v10 offset:0
    ds_read_b64_tr_b16 v[194:195], v10 offset:4096
    ds_read_b64_tr_b16 v[196:197], v10 offset:8192
    ds_read_b64_tr_b16 v[198:199], v10 offset:12288
    ds_read_b64_tr_b16 v[200:201], v11 offset:0
    ds_read_b64_tr_b16 v[202:203], v11 offset:4096
    ds_read_b64_tr_b16 v[204:205], v11 offset:8192
    ds_read_b64_tr_b16 v[206:207], v11 offset:12288
    s_waitcnt lgkmcnt(8)
    v_mfma_f32_16x16x32_bf16 v[188:191], v[160:163], v[96:99], 0
    v_mfma_f32_16x16x32_bf16 v[188:191], v[164:167], v[100:103], v[188:191]
    v_mfma_f32_16x16x32_bf16 v[188:191], v[168:171], v[104:107], v[188:191]
    v_mfma_f32_16x16x32_bf16 v[188:191], v[172:175], v[108:111], v[188:191]
    v_and_b32 v14, 15, v1
    v_lshrrev_b32 v15, 5, v1
    v_lshl_add_u32 v14, v15, 5, v14
    v_lshlrev_b32 v249, 4, v14
    v_bfe_u32 v15, v1, 4, 1
    v_lshl_add_u32 v249, v15, 3, v249
    s_and_b32 s48, s56, 1
    s_lshl_b32 s48, s48, 8
    v_add_u32 v249, s48, v249
    s_lshl_b32 s48, s37, 1
    s_lshr_b32 s49, s56, 1
    s_add_u32 s48, s48, s49
    s_lshl_b32 s48, s48, 8
    s_lshl_b32 s49, s38, 3
    s_add_u32 s48, s48, s49
    s_lshl_b32 s49, s55, 2
    s_add_u32 s48, s48, s49
    s_lshl_b32 s50, s48, 10
    s_mov_b32 s53, 0x3db504f3
    s_mov_b32 s54, 0x3fb8aa3b
    v_cvt_pk_bf16_f32 v14, v176, v177
    v_cvt_pk_bf16_f32 v15, v178, v179
    v_lshlrev_b32 v176, 16, v14
    v_and_b32 v177, 0xffff0000, v14
    v_lshlrev_b32 v178, 16, v15
    v_and_b32 v179, 0xffff0000, v15
    v_mul_f32 v176, s53, v176
    v_mul_f32 v177, s53, v177
    v_mul_f32 v178, s53, v178
    v_mul_f32 v179, s53, v179
    v_cvt_pk_bf16_f32 v14, v176, v177
    v_cvt_pk_bf16_f32 v15, v178, v179
    v_lshlrev_b32 v176, 16, v14
    v_and_b32 v177, 0xffff0000, v14
    v_lshlrev_b32 v178, 16, v15
    v_and_b32 v179, 0xffff0000, v15
    v_cvt_pk_bf16_f32 v14, v180, v181
    v_cvt_pk_bf16_f32 v15, v182, v183
    v_lshlrev_b32 v180, 16, v14
    v_and_b32 v181, 0xffff0000, v14
    v_lshlrev_b32 v182, 16, v15
    v_and_b32 v183, 0xffff0000, v15
    v_mul_f32 v180, s53, v180
    v_mul_f32 v181, s53, v181
    v_mul_f32 v182, s53, v182
    v_mul_f32 v183, s53, v183
    v_cvt_pk_bf16_f32 v14, v180, v181
    v_cvt_pk_bf16_f32 v15, v182, v183
    v_lshlrev_b32 v180, 16, v14
    v_and_b32 v181, 0xffff0000, v14
    v_lshlrev_b32 v182, 16, v15
    v_and_b32 v183, 0xffff0000, v15
    v_cvt_pk_bf16_f32 v14, v184, v185
    v_cvt_pk_bf16_f32 v15, v186, v187
    v_lshlrev_b32 v184, 16, v14
    v_and_b32 v185, 0xffff0000, v14
    v_lshlrev_b32 v186, 16, v15
    v_and_b32 v187, 0xffff0000, v15
    v_mul_f32 v184, s53, v184
    v_mul_f32 v185, s53, v185
    v_mul_f32 v186, s53, v186
    v_mul_f32 v187, s53, v187
    v_cvt_pk_bf16_f32 v14, v184, v185
    v_cvt_pk_bf16_f32 v15, v186, v187
    v_lshlrev_b32 v184, 16, v14
    v_and_b32 v185, 0xffff0000, v14
    v_lshlrev_b32 v186, 16, v15
    v_and_b32 v187, 0xffff0000, v15
    v_cvt_pk_bf16_f32 v14, v188, v189
    v_cvt_pk_bf16_f32 v15, v190, v191
    v_lshlrev_b32 v188, 16, v14
    v_and_b32 v189, 0xffff0000, v14
    v_lshlrev_b32 v190, 16, v15
    v_and_b32 v191, 0xffff0000, v15
    v_mul_f32 v188, s53, v188
    v_mul_f32 v189, s53, v189
    v_mul_f32 v190, s53, v190
    v_mul_f32 v191, s53, v191
    v_cvt_pk_bf16_f32 v14, v188, v189
    v_cvt_pk_bf16_f32 v15, v190, v191
    v_lshlrev_b32 v188, 16, v14
    v_and_b32 v189, 0xffff0000, v14
    v_lshlrev_b32 v190, 16, v15
    v_and_b32 v191, 0xffff0000, v15
    v_max3_f32 v246, v176, v177, v178
    v_max3_f32 v246, v246, v179, v180
    v_max3_f32 v246, v246, v181, v182
    v_max3_f32 v246, v246, v183, v184
    v_max3_f32 v246, v246, v185, v186
    v_max3_f32 v246, v246, v187, v188
    v_max3_f32 v246, v246, v189, v190
    v_max_f32 v246, v246, v191
    v_mov_b32 v248, v246
    s_nop 1
    v_permlane16_swap_b32 v246, v248
    v_max_f32 v246, v246, v248
    v_mov_b32 v248, v246
    s_nop 1
    v_permlane32_swap_b32 v246, v248
    v_max_f32 v246, v246, v248
    v_mul_f32 v246, s54, v246
    v_fma_f32 v176, v176, s54, -v246
    v_fma_f32 v177, v177, s54, -v246
    v_fma_f32 v178, v178, s54, -v246
    v_fma_f32 v179, v179, s54, -v246
    v_fma_f32 v180, v180, s54, -v246
    v_fma_f32 v181, v181, s54, -v246
    v_fma_f32 v182, v182, s54, -v246
    v_fma_f32 v183, v183, s54, -v246
    v_fma_f32 v184, v184, s54, -v246
    v_fma_f32 v185, v185, s54, -v246
    v_fma_f32 v186, v186, s54, -v246
    v_fma_f32 v187, v187, s54, -v246
    v_fma_f32 v188, v188, s54, -v246
    v_fma_f32 v189, v189, s54, -v246
    v_fma_f32 v190, v190, s54, -v246
    v_fma_f32 v191, v191, s54, -v246
    v_exp_f32 v176, v176
    v_exp_f32 v177, v177
    v_exp_f32 v178, v178
    v_exp_f32 v179, v179
    v_exp_f32 v180, v180
    v_exp_f32 v181, v181
    v_exp_f32 v182, v182
    v_exp_f32 v183, v183
    v_exp_f32 v184, v184
    v_exp_f32 v185, v185
    v_exp_f32 v186, v186
    v_exp_f32 v187, v187
    v_exp_f32 v188, v188
    v_exp_f32 v189, v189
    v_exp_f32 v190, v190
    v_exp_f32 v191, v191
    ds_read_b64_tr_b16 v[208:209], v12 offset:0
    ds_read_b64_tr_b16 v[210:211], v12 offset:4096
    ds_read_b64_tr_b16 v[212:213], v12 offset:8192
    ds_read_b64_tr_b16 v[214:215], v12 offset:12288
    ds_read_b64_tr_b16 v[216:217], v13 offset:0
    ds_read_b64_tr_b16 v[218:219], v13 offset:4096
    ds_read_b64_tr_b16 v[220:221], v13 offset:8192
    ds_read_b64_tr_b16 v[222:223], v13 offset:12288
    v_add_f32 v247, v176, v177
    v_add_f32 v247, v247, v178
    v_add_f32 v247, v247, v179
    v_add_f32 v247, v247, v180
    v_add_f32 v247, v247, v181
    v_add_f32 v247, v247, v182
    v_add_f32 v247, v247, v183
    v_add_f32 v247, v247, v184
    v_add_f32 v247, v247, v185
    v_add_f32 v247, v247, v186
    v_add_f32 v247, v247, v187
    v_add_f32 v247, v247, v188
    v_add_f32 v247, v247, v189
    v_add_f32 v247, v247, v190
    v_add_f32 v247, v247, v191
    v_mov_b32 v248, v247
    s_nop 1
    v_permlane16_swap_b32 v247, v248
    v_add_f32 v247, v247, v248
    v_mov_b32 v248, v247
    s_nop 1
    v_permlane32_swap_b32 v247, v248
    v_add_f32 v247, v247, v248
    v_rcp_f32 v247, v247
    s_nop 0
    v_mul_f32 v176, v176, v247
    v_mul_f32 v177, v177, v247
    v_mul_f32 v178, v178, v247
    v_mul_f32 v179, v179, v247
    v_mul_f32 v180, v180, v247
    v_mul_f32 v181, v181, v247
    v_mul_f32 v182, v182, v247
    v_mul_f32 v183, v183, v247
    v_mul_f32 v184, v184, v247
    v_mul_f32 v185, v185, v247
    v_mul_f32 v186, v186, v247
    v_mul_f32 v187, v187, v247
    v_mul_f32 v188, v188, v247
    v_mul_f32 v189, v189, v247
    v_mul_f32 v190, v190, v247
    v_mul_f32 v191, v191, v247
    v_cvt_pk_bf16_f32 v224, v176, v177
    v_cvt_pk_bf16_f32 v225, v178, v179
    v_cvt_pk_bf16_f32 v226, v180, v181
    v_cvt_pk_bf16_f32 v227, v182, v183
    v_cvt_pk_bf16_f32 v228, v184, v185
    v_cvt_pk_bf16_f32 v229, v186, v187
    v_cvt_pk_bf16_f32 v230, v188, v189
    v_cvt_pk_bf16_f32 v231, v190, v191
    s_waitcnt lgkmcnt(0)
    v_mfma_f32_16x16x32_bf16 v[232:235], v[192:195], v[224:227], 0
    v_mfma_f32_16x16x32_bf16 v[236:239], v[200:203], v[224:227], 0
    v_mfma_f32_16x16x32_bf16 v[240:243], v[208:211], v[224:227], 0
    v_mfma_f32_16x16x32_bf16 v[244:247], v[216:219], v[224:227], 0
    v_mfma_f32_16x16x32_bf16 v[232:235], v[196:199], v[228:231], v[232:235]
    v_mfma_f32_16x16x32_bf16 v[236:239], v[204:207], v[228:231], v[236:239]
    v_mfma_f32_16x16x32_bf16 v[240:243], v[212:215], v[228:231], v[240:243]
    v_mfma_f32_16x16x32_bf16 v[244:247], v[220:223], v[228:231], v[244:247]
    s_nop 4
    v_cvt_pk_bf16_f32 v176, v232, v233
    s_nop 3
    v_cvt_pk_bf16_f32 v177, v234, v235
    buffer_store_dwordx2 v[176:177], v249, s[32:35], s50 offen offset:0
    s_nop 2
    v_cvt_pk_bf16_f32 v178, v236, v237
    s_nop 1
    v_cvt_pk_bf16_f32 v179, v238, v239
    buffer_store_dwordx2 v[178:179], v249, s[32:35], s50 offen offset:1024
    s_nop 0
    v_cvt_pk_bf16_f32 v180, v240, v241
    v_cvt_pk_bf16_f32 v181, v242, v243
    buffer_store_dwordx2 v[180:181], v249, s[32:35], s50 offen offset:2048
    v_cvt_pk_bf16_f32 v182, v244, v245
    v_cvt_pk_bf16_f32 v183, v246, v247
    buffer_store_dwordx2 v[182:183], v249, s[32:35], s50 offen offset:3072
k1_END:
    s_endpgm

.globl mha_k2_kernel
.p2align 8
.type mha_k2_kernel,@function
mha_k2_kernel:
    s_cmp_ge_u32 s2, 256
    s_cbranch_scc1 k2_END
    s_load_dwordx2 s[4:5], s[0:1], 32
    s_load_dwordx2 s[6:7], s[0:1], 56
    s_load_dwordx2 s[8:9], s[0:1], 40
    v_and_b32 v1, 63, v0
    v_lshrrev_b32 v6, 6, v0
    s_nop 0
    v_readfirstlane_b32 s24, v6
    s_and_b32 s31, s2, 1
    s_lshl_b32 s31, s31, 3
    s_bfe_u32 s32, s2, 0x30003
    s_add_u32 s25, s31, s32
    s_bfe_u32 s31, s2, 0x20001
    s_lshl_b32 s31, s31, 2
    s_lshr_b32 s32, s2, 6
    s_add_u32 s26, s31, s32
    v_lshrrev_b32 v6, 4, v1
    v_bfe_u32 v7, v1, 3, 1
    v_lshl_add_u32 v7, v6, 1, v7
    v_bfe_u32 v8, v1, 2, 1
    v_and_b32 v9, 1, v6
    v_xor_b32 v8, v8, v9
    v_and_b32 v9, 3, v1
    v_lshlrev_b32 v2, 11, v7
    v_lshl_add_u32 v2, v8, 6, v2
    v_lshl_add_u32 v2, v9, 4, v2
    v_lshlrev_b32 v3, 4, v1
    v_bfe_u32 v6, v1, 5, 1
    v_lshlrev_b32 v4, 10, v6
    v_bfe_u32 v6, v1, 3, 1
    v_lshl_add_u32 v4, v6, 8, v4
    v_lshl_add_u32 v4, v6, 6, v4
    v_bfe_u32 v6, v1, 2, 1
    v_lshl_add_u32 v4, v6, 7, v4
    v_bfe_u32 v6, v1, 4, 1
    v_lshl_add_u32 v4, v6, 5, v4
    v_and_b32 v6, 3, v1
    v_lshl_add_u32 v4, v6, 3, v4
    s_mul_i32 s29, s24, 16384
    v_add_u32 v4, s29, v4
    v_xor_b32 v5, 64, v4
    s_and_b32 s31, s25, 7
    s_and_b32 s32, s26, 3
    s_lshl_b32 s32, s32, 1
    s_add_u32 s31, s31, s32
    s_mul_i32 s36, s31, 2
    s_and_b32 s36, s36, 15
    s_mov_b32 s33, 0
    v_mov_b32 v64, 0
    v_mov_b32 v65, 0
    v_mov_b32 v66, 0
    v_mov_b32 v67, 0
    v_mov_b32 v68, 0
    v_mov_b32 v69, 0
    v_mov_b32 v70, 0
    v_mov_b32 v71, 0
    v_mov_b32 v72, 0
    v_mov_b32 v73, 0
    v_mov_b32 v74, 0
    v_mov_b32 v75, 0
    v_mov_b32 v76, 0
    v_mov_b32 v77, 0
    v_mov_b32 v78, 0
    v_mov_b32 v79, 0
    v_mov_b32 v80, 0
    v_mov_b32 v81, 0
    v_mov_b32 v82, 0
    v_mov_b32 v83, 0
    v_mov_b32 v84, 0
    v_mov_b32 v85, 0
    v_mov_b32 v86, 0
    v_mov_b32 v87, 0
    v_mov_b32 v88, 0
    v_mov_b32 v89, 0
    v_mov_b32 v90, 0
    v_mov_b32 v91, 0
    v_mov_b32 v92, 0
    v_mov_b32 v93, 0
    v_mov_b32 v94, 0
    v_mov_b32 v95, 0
    s_waitcnt lgkmcnt(0)
    s_mov_b32 s12, s4
    s_and_b32 s13, s5, 0xffff
    s_mov_b32 s14, 0x800000
    s_mov_b32 s15, 0x00020000
    s_mul_i32 s34, s24, 1048576
    s_lshl_b32 s31, s26, 7
    s_add_u32 s34, s34, s31
    s_lshl_b32 s31, s25, 18
    s_mul_i32 s32, s24, 32768
    s_add_u32 s35, s31, s32
    s_mov_b32 s16, s6
    s_and_b32 s17, s7, 0xffff
    s_mov_b32 s18, 0x400000
    s_mov_b32 s19, 0x00020000
    s_mov_b32 s20, s8
    s_and_b32 s21, s9, 0xffff
    s_mov_b32 s22, 0x100000
    s_mov_b32 s23, 0x00020000
    s_add_u32 s37, s33, s36
    s_and_b32 s37, s37, 15
    s_and_b32 s31, s33, 16
    s_or_b32 s37, s37, s31
    s_lshl_b32 s31, s37, 15
    s_add_u32 s27, s34, s31
    s_lshl_b32 s32, s37, 10
    s_add_u32 s28, s35, s32
    s_add_u32 m0, s29, 0
    buffer_load_dwordx4 v[128:131], v3, s[16:19], s28 offen
    buffer_load_dwordx4 v2, s[12:15], s27 offen  lds
    s_add_u32 s27, s27, 16384
    s_add_u32 m0, s29, 1024
    s_add_u32 s33, s33, 1
    buffer_load_dwordx4 v2, s[12:15], s27 offen  lds
    s_add_u32 s37, s33, s36
    s_and_b32 s37, s37, 15
    s_and_b32 s31, s33, 16
    s_or_b32 s37, s37, s31
    s_lshl_b32 s31, s37, 15
    s_add_u32 s27, s34, s31
    s_lshl_b32 s32, s37, 10
    s_add_u32 s28, s35, s32
    s_add_u32 m0, s29, 2048
    buffer_load_dwordx4 v[132:135], v3, s[16:19], s28 offen
    buffer_load_dwordx4 v2, s[12:15], s27 offen  lds
    s_add_u32 s27, s27, 16384
    s_add_u32 m0, s29, 3072
    s_add_u32 s33, s33, 1
    buffer_load_dwordx4 v2, s[12:15], s27 offen  lds
    s_add_u32 s37, s33, s36
    s_and_b32 s37, s37, 15
    s_and_b32 s31, s33, 16
    s_or_b32 s37, s37, s31
    s_lshl_b32 s31, s37, 15
    s_add_u32 s27, s34, s31
    s_lshl_b32 s32, s37, 10
    s_add_u32 s28, s35, s32
    s_add_u32 m0, s29, 4096
    buffer_load_dwordx4 v[136:139], v3, s[16:19], s28 offen
    buffer_load_dwordx4 v2, s[12:15], s27 offen  lds
    s_add_u32 s27, s27, 16384
    s_add_u32 m0, s29, 5120
    s_add_u32 s33, s33, 1
    buffer_load_dwordx4 v2, s[12:15], s27 offen  lds
    s_add_u32 s37, s33, s36
    s_and_b32 s37, s37, 15
    s_and_b32 s31, s33, 16
    s_or_b32 s37, s37, s31
    s_lshl_b32 s31, s37, 15
    s_add_u32 s27, s34, s31
    s_lshl_b32 s32, s37, 10
    s_add_u32 s28, s35, s32
    s_add_u32 m0, s29, 6144
    buffer_load_dwordx4 v[140:143], v3, s[16:19], s28 offen
    buffer_load_dwordx4 v2, s[12:15], s27 offen  lds
    s_add_u32 s27, s27, 16384
    s_add_u32 m0, s29, 7168
    s_add_u32 s33, s33, 1
    buffer_load_dwordx4 v2, s[12:15], s27 offen  lds
    s_add_u32 s37, s33, s36
    s_and_b32 s37, s37, 15
    s_and_b32 s31, s33, 16
    s_or_b32 s37, s37, s31
    s_lshl_b32 s31, s37, 15
    s_add_u32 s27, s34, s31
    s_lshl_b32 s32, s37, 10
    s_add_u32 s28, s35, s32
    s_add_u32 m0, s29, 8192
    buffer_load_dwordx4 v[144:147], v3, s[16:19], s28 offen
    buffer_load_dwordx4 v2, s[12:15], s27 offen  lds
    s_add_u32 s27, s27, 16384
    s_add_u32 m0, s29, 9216
    s_add_u32 s33, s33, 1
    buffer_load_dwordx4 v2, s[12:15], s27 offen  lds
    s_add_u32 s37, s33, s36
    s_and_b32 s37, s37, 15
    s_and_b32 s31, s33, 16
    s_or_b32 s37, s37, s31
    s_lshl_b32 s31, s37, 15
    s_add_u32 s27, s34, s31
    s_lshl_b32 s32, s37, 10
    s_add_u32 s28, s35, s32
    s_add_u32 m0, s29, 10240
    buffer_load_dwordx4 v[148:151], v3, s[16:19], s28 offen
    buffer_load_dwordx4 v2, s[12:15], s27 offen  lds
    s_add_u32 s27, s27, 16384
    s_add_u32 m0, s29, 11264
    s_add_u32 s33, s33, 1
    buffer_load_dwordx4 v2, s[12:15], s27 offen  lds
    s_add_u32 s37, s33, s36
    s_and_b32 s37, s37, 15
    s_and_b32 s31, s33, 16
    s_or_b32 s37, s37, s31
    s_lshl_b32 s31, s37, 15
    s_add_u32 s27, s34, s31
    s_lshl_b32 s32, s37, 10
    s_add_u32 s28, s35, s32
    s_add_u32 m0, s29, 12288
    buffer_load_dwordx4 v[152:155], v3, s[16:19], s28 offen
    buffer_load_dwordx4 v2, s[12:15], s27 offen  lds
    s_add_u32 s27, s27, 16384
    s_add_u32 m0, s29, 13312
    s_add_u32 s33, s33, 1
    buffer_load_dwordx4 v2, s[12:15], s27 offen  lds
    s_waitcnt vmcnt(18)
    ds_read_b64_tr_b16 v[96:97], v4 offset:0
    ds_read_b64_tr_b16 v[98:99], v4 offset:512
    ds_read_b64_tr_b16 v[100:101], v5 offset:0
    ds_read_b64_tr_b16 v[102:103], v5 offset:512
    s_mov_b32 s30, 4
k2_LOOP:
    s_add_u32 s37, s33, s36
    s_and_b32 s37, s37, 15
    s_and_b32 s31, s33, 16
    s_or_b32 s37, s37, s31
    s_lshl_b32 s31, s37, 15
    s_add_u32 s27, s34, s31
    s_lshl_b32 s32, s37, 10
    s_add_u32 s28, s35, s32
    s_add_u32 m0, s29, 14336
    buffer_load_dwordx4 v[156:159], v3, s[16:19], s28 offen
    buffer_load_dwordx4 v2, s[12:15], s27 offen  lds
    s_add_u32 s27, s27, 16384
    s_add_u32 m0, s29, 15360
    s_add_u32 s33, s33, 1
    buffer_load_dwordx4 v2, s[12:15], s27 offen  lds
    s_waitcnt vmcnt(18)
    ds_read_b64_tr_b16 v[104:105], v4 offset:2048
    ds_read_b64_tr_b16 v[106:107], v4 offset:2560
    ds_read_b64_tr_b16 v[108:109], v5 offset:2048
    ds_read_b64_tr_b16 v[110:111], v5 offset:2560
    s_waitcnt lgkmcnt(4)
    v_mfma_f32_32x32x16_bf16 v[64:79], v[96:99], v[128:131], v[64:79]
    v_mfma_f32_32x32x16_bf16 v[80:95], v[100:103], v[128:131], v[80:95]
    s_cmp_eq_u32 s30, 1
    s_cselect_b32 s14, 0, s14
    s_cselect_b32 s18, 0, s18
    s_add_u32 s37, s33, s36
    s_and_b32 s37, s37, 15
    s_and_b32 s31, s33, 16
    s_or_b32 s37, s37, s31
    s_lshl_b32 s31, s37, 15
    s_add_u32 s27, s34, s31
    s_lshl_b32 s32, s37, 10
    s_add_u32 s28, s35, s32
    s_add_u32 m0, s29, 0
    buffer_load_dwordx4 v[128:131], v3, s[16:19], s28 offen
    buffer_load_dwordx4 v2, s[12:15], s27 offen  lds
    s_add_u32 s27, s27, 16384
    s_add_u32 m0, s29, 1024
    s_add_u32 s33, s33, 1
    buffer_load_dwordx4 v2, s[12:15], s27 offen  lds
    s_waitcnt vmcnt(18)
    ds_read_b64_tr_b16 v[96:97], v4 offset:4096
    ds_read_b64_tr_b16 v[98:99], v4 offset:4608
    ds_read_b64_tr_b16 v[100:101], v5 offset:4096
    ds_read_b64_tr_b16 v[102:103], v5 offset:4608
    s_waitcnt lgkmcnt(4)
    v_mfma_f32_32x32x16_bf16 v[64:79], v[104:107], v[132:135], v[64:79]
    v_mfma_f32_32x32x16_bf16 v[80:95], v[108:111], v[132:135], v[80:95]
    s_add_u32 s37, s33, s36
    s_and_b32 s37, s37, 15
    s_and_b32 s31, s33, 16
    s_or_b32 s37, s37, s31
    s_lshl_b32 s31, s37, 15
    s_add_u32 s27, s34, s31
    s_lshl_b32 s32, s37, 10
    s_add_u32 s28, s35, s32
    s_add_u32 m0, s29, 2048
    buffer_load_dwordx4 v[132:135], v3, s[16:19], s28 offen
    buffer_load_dwordx4 v2, s[12:15], s27 offen  lds
    s_add_u32 s27, s27, 16384
    s_add_u32 m0, s29, 3072
    s_add_u32 s33, s33, 1
    buffer_load_dwordx4 v2, s[12:15], s27 offen  lds
    s_waitcnt vmcnt(18)
    ds_read_b64_tr_b16 v[104:105], v4 offset:6144
    ds_read_b64_tr_b16 v[106:107], v4 offset:6656
    ds_read_b64_tr_b16 v[108:109], v5 offset:6144
    ds_read_b64_tr_b16 v[110:111], v5 offset:6656
    s_waitcnt lgkmcnt(4)
    v_mfma_f32_32x32x16_bf16 v[64:79], v[96:99], v[136:139], v[64:79]
    v_mfma_f32_32x32x16_bf16 v[80:95], v[100:103], v[136:139], v[80:95]
    s_add_u32 s37, s33, s36
    s_and_b32 s37, s37, 15
    s_and_b32 s31, s33, 16
    s_or_b32 s37, s37, s31
    s_lshl_b32 s31, s37, 15
    s_add_u32 s27, s34, s31
    s_lshl_b32 s32, s37, 10
    s_add_u32 s28, s35, s32
    s_add_u32 m0, s29, 4096
    buffer_load_dwordx4 v[136:139], v3, s[16:19], s28 offen
    buffer_load_dwordx4 v2, s[12:15], s27 offen  lds
    s_add_u32 s27, s27, 16384
    s_add_u32 m0, s29, 5120
    s_add_u32 s33, s33, 1
    buffer_load_dwordx4 v2, s[12:15], s27 offen  lds
    s_waitcnt vmcnt(18)
    ds_read_b64_tr_b16 v[96:97], v4 offset:8192
    ds_read_b64_tr_b16 v[98:99], v4 offset:8704
    ds_read_b64_tr_b16 v[100:101], v5 offset:8192
    ds_read_b64_tr_b16 v[102:103], v5 offset:8704
    s_waitcnt lgkmcnt(4)
    v_mfma_f32_32x32x16_bf16 v[64:79], v[104:107], v[140:143], v[64:79]
    v_mfma_f32_32x32x16_bf16 v[80:95], v[108:111], v[140:143], v[80:95]
    s_add_u32 s37, s33, s36
    s_and_b32 s37, s37, 15
    s_and_b32 s31, s33, 16
    s_or_b32 s37, s37, s31
    s_lshl_b32 s31, s37, 15
    s_add_u32 s27, s34, s31
    s_lshl_b32 s32, s37, 10
    s_add_u32 s28, s35, s32
    s_add_u32 m0, s29, 6144
    buffer_load_dwordx4 v[140:143], v3, s[16:19], s28 offen
    buffer_load_dwordx4 v2, s[12:15], s27 offen  lds
    s_add_u32 s27, s27, 16384
    s_add_u32 m0, s29, 7168
    s_add_u32 s33, s33, 1
    buffer_load_dwordx4 v2, s[12:15], s27 offen  lds
    s_waitcnt vmcnt(18)
    ds_read_b64_tr_b16 v[104:105], v4 offset:10240
    ds_read_b64_tr_b16 v[106:107], v4 offset:10752
    ds_read_b64_tr_b16 v[108:109], v5 offset:10240
    ds_read_b64_tr_b16 v[110:111], v5 offset:10752
    s_waitcnt lgkmcnt(4)
    v_mfma_f32_32x32x16_bf16 v[64:79], v[96:99], v[144:147], v[64:79]
    v_mfma_f32_32x32x16_bf16 v[80:95], v[100:103], v[144:147], v[80:95]
    s_add_u32 s37, s33, s36
    s_and_b32 s37, s37, 15
    s_and_b32 s31, s33, 16
    s_or_b32 s37, s37, s31
    s_lshl_b32 s31, s37, 15
    s_add_u32 s27, s34, s31
    s_lshl_b32 s32, s37, 10
    s_add_u32 s28, s35, s32
    s_add_u32 m0, s29, 8192
    buffer_load_dwordx4 v[144:147], v3, s[16:19], s28 offen
    buffer_load_dwordx4 v2, s[12:15], s27 offen  lds
    s_add_u32 s27, s27, 16384
    s_add_u32 m0, s29, 9216
    s_add_u32 s33, s33, 1
    buffer_load_dwordx4 v2, s[12:15], s27 offen  lds
    s_waitcnt vmcnt(18)
    ds_read_b64_tr_b16 v[96:97], v4 offset:12288
    ds_read_b64_tr_b16 v[98:99], v4 offset:12800
    ds_read_b64_tr_b16 v[100:101], v5 offset:12288
    ds_read_b64_tr_b16 v[102:103], v5 offset:12800
    s_waitcnt lgkmcnt(4)
    v_mfma_f32_32x32x16_bf16 v[64:79], v[104:107], v[148:151], v[64:79]
    v_mfma_f32_32x32x16_bf16 v[80:95], v[108:111], v[148:151], v[80:95]
    s_add_u32 s37, s33, s36
    s_and_b32 s37, s37, 15
    s_and_b32 s31, s33, 16
    s_or_b32 s37, s37, s31
    s_lshl_b32 s31, s37, 15
    s_add_u32 s27, s34, s31
    s_lshl_b32 s32, s37, 10
    s_add_u32 s28, s35, s32
    s_add_u32 m0, s29, 10240
    buffer_load_dwordx4 v[148:151], v3, s[16:19], s28 offen
    buffer_load_dwordx4 v2, s[12:15], s27 offen  lds
    s_add_u32 s27, s27, 16384
    s_add_u32 m0, s29, 11264
    s_add_u32 s33, s33, 1
    buffer_load_dwordx4 v2, s[12:15], s27 offen  lds
    s_waitcnt vmcnt(18)
    ds_read_b64_tr_b16 v[104:105], v4 offset:14336
    ds_read_b64_tr_b16 v[106:107], v4 offset:14848
    ds_read_b64_tr_b16 v[108:109], v5 offset:14336
    ds_read_b64_tr_b16 v[110:111], v5 offset:14848
    s_waitcnt lgkmcnt(4)
    v_mfma_f32_32x32x16_bf16 v[64:79], v[96:99], v[152:155], v[64:79]
    v_mfma_f32_32x32x16_bf16 v[80:95], v[100:103], v[152:155], v[80:95]
    s_add_u32 s37, s33, s36
    s_and_b32 s37, s37, 15
    s_and_b32 s31, s33, 16
    s_or_b32 s37, s37, s31
    s_lshl_b32 s31, s37, 15
    s_add_u32 s27, s34, s31
    s_lshl_b32 s32, s37, 10
    s_add_u32 s28, s35, s32
    s_add_u32 m0, s29, 12288
    buffer_load_dwordx4 v[152:155], v3, s[16:19], s28 offen
    buffer_load_dwordx4 v2, s[12:15], s27 offen  lds
    s_add_u32 s27, s27, 16384
    s_add_u32 m0, s29, 13312
    s_add_u32 s33, s33, 1
    buffer_load_dwordx4 v2, s[12:15], s27 offen  lds
    s_waitcnt vmcnt(18)
    ds_read_b64_tr_b16 v[96:97], v4 offset:0
    ds_read_b64_tr_b16 v[98:99], v4 offset:512
    ds_read_b64_tr_b16 v[100:101], v5 offset:0
    ds_read_b64_tr_b16 v[102:103], v5 offset:512
    s_waitcnt lgkmcnt(4)
    v_mfma_f32_32x32x16_bf16 v[64:79], v[104:107], v[156:159], v[64:79]
    v_mfma_f32_32x32x16_bf16 v[80:95], v[108:111], v[156:159], v[80:95]
    s_sub_u32 s30, s30, 1
    s_cmp_lg_u32 s30, 0
    s_cbranch_scc1 k2_LOOP
    s_waitcnt vmcnt(0) lgkmcnt(0)
    v_lshlrev_b32 v10, 4, v1
    v_add_u32 v6, s29, v10
    s_nop 4
    ds_write_b128 v6, v[64:67] offset:0
    s_nop 3
    ds_write_b128 v6, v[68:71] offset:1024
    s_nop 2
    ds_write_b128 v6, v[72:75] offset:2048
    s_nop 1
    ds_write_b128 v6, v[76:79] offset:3072
    s_nop 1
    ds_write_b128 v6, v[80:83] offset:4096
    s_nop 0
    ds_write_b128 v6, v[84:87] offset:5120
    ds_write_b128 v6, v[88:91] offset:6144
    ds_write_b128 v6, v[92:95] offset:7168
    s_lshl_b32 s31, s24, 10
    v_add_u32 v10, s31, v10
    v_add_u32 v7, 65536, v10
    s_waitcnt lgkmcnt(0)
    s_barrier
    ds_read_b128 v[128:131], v10 offset:0
    ds_read_b128 v[132:135], v10 offset:16384
    ds_read_b128 v[136:139], v10 offset:32768
    ds_read_b128 v[140:143], v10 offset:49152
    ds_read_b128 v[144:147], v7 offset:0
    ds_read_b128 v[148:151], v7 offset:16384
    ds_read_b128 v[152:155], v7 offset:32768
    ds_read_b128 v[156:159], v7 offset:49152
    v_and_b32 v11, 31, v1
    v_lshlrev_b32 v11, 11, v11
    v_lshrrev_b32 v6, 5, v1
    v_lshl_add_u32 v11, v6, 3, v11
    s_lshl_b32 s31, s25, 16
    s_lshl_b32 s32, s26, 7
    s_add_u32 s31, s31, s32
    s_lshl_b32 s32, s24, 4
    s_add_u32 s31, s31, s32
    s_waitcnt lgkmcnt(0)
    v_add_f32 v128, v128, v144
    v_add_f32 v129, v129, v145
    v_add_f32 v130, v130, v146
    v_add_f32 v131, v131, v147
    v_add_f32 v132, v132, v148
    v_add_f32 v133, v133, v149
    v_add_f32 v134, v134, v150
    v_add_f32 v135, v135, v151
    v_add_f32 v136, v136, v152
    v_add_f32 v137, v137, v153
    v_add_f32 v138, v138, v154
    v_add_f32 v139, v139, v155
    v_add_f32 v140, v140, v156
    v_add_f32 v141, v141, v157
    v_add_f32 v142, v142, v158
    v_add_f32 v143, v143, v159
    v_add_f32 v128, v128, v136
    v_add_f32 v129, v129, v137
    v_add_f32 v130, v130, v138
    v_add_f32 v131, v131, v139
    v_add_f32 v132, v132, v140
    v_add_f32 v133, v133, v141
    v_add_f32 v134, v134, v142
    v_add_f32 v135, v135, v143
    v_add_f32 v128, v128, v132
    v_add_f32 v129, v129, v133
    v_add_f32 v130, v130, v134
    v_add_f32 v131, v131, v135
    v_cvt_pk_bf16_f32 v96, v128, v129
    v_cvt_pk_bf16_f32 v97, v130, v131
    buffer_store_dwordx2 v[96:97], v11, s[20:23], s31 offen offset:0
k2_END:
    s_endpgm

.section .rodata,"a"
.p2align 6
.amdhsa_kernel mha_k1_kernel
  .amdhsa_next_free_vgpr 256
  .amdhsa_next_free_sgpr 102
  .amdhsa_accum_offset 256
  .amdhsa_group_segment_fixed_size 0
  .amdhsa_kernarg_size 64
  .amdhsa_user_sgpr_count 2
  .amdhsa_user_sgpr_kernarg_segment_ptr 1
  .amdhsa_system_sgpr_workgroup_id_x 1
.end_amdhsa_kernel
.p2align 6
.amdhsa_kernel mha_k2_kernel
  .amdhsa_next_free_vgpr 256
  .amdhsa_next_free_sgpr 102
  .amdhsa_accum_offset 256
  .amdhsa_group_segment_fixed_size 0
  .amdhsa_kernarg_size 64
  .amdhsa_user_sgpr_count 2
  .amdhsa_user_sgpr_kernarg_segment_ptr 1
  .amdhsa_system_sgpr_workgroup_id_x 1
.end_amdhsa_kernel
```
